```python
import torch

def _softmax(x, axis=-1):
    return torch.softmax(x, dim=axis)
def _gelu(x):
    return torch.nn.functional.gelu(x, approximate="tanh")
def _silu(x):
    return torch.nn.functional.silu(x)
def _sigmoid(x):
    return torch.sigmoid(x)
def _layernorm(x, axis=-1, eps=1e-5):
    m = x.mean(dim=axis, keepdim=True)
    v = x.var(dim=axis, keepdim=True, unbiased=False)
    return (x - m) / torch.sqrt(v + eps)
def _scatter_add(tgt, idx, src, axis=0):
    return tgt.clone().index_add_(axis, idx, src)
def _segment_sum(src, seg, n):
    out = torch.zeros((n,) + src.shape[1:], dtype=src.dtype)
    return out.index_add_(0, seg, src)
def _pad(x, pw):
    flat = tuple(v for pair in reversed(pw) for v in pair)
    return torch.nn.functional.pad(x, flat)

kernel_name = 'standalone__deep_cross_wide_deep__recsys'

def setup_inputs():

    _w = (lambda a: (lambda t: t.to(torch.bfloat16) if t.is_floating_point() else t)(torch.as_tensor(a)))
    B, F, D = 4096, 26, 128
    V, Nd = min(100000, 100000), 13
    Din = F * D
    H = 4 * D
    return {
        "idx": _w((lambda lo, hi, *s: torch.randint(lo, hi, s))(0, V, B, F).to(torch.int64)),
        "table": _w((lambda *s: torch.randn(*s, dtype=torch.bfloat16) * 1.6)(V, D) * 0.05),
        "x_wide": _w((lambda *s: torch.randn(*s, dtype=torch.bfloat16) * 0.8)(B, Nd)),
        "w_wide": _w((lambda *s: torch.randn(*s, dtype=torch.bfloat16) * 0.8)(Nd) * 0.05),
        "b_wide": _w((lambda *s: torch.randn(*s, dtype=torch.bfloat16) * 0.8)(1) * 0.01),
        "W1": _w((lambda *s: torch.randn(*s, dtype=torch.bfloat16) * 1.6)(Din, H) * (2.0 / Din) ** 0.5),
        "b1": _w((lambda *s: torch.randn(*s, dtype=torch.bfloat16) * 1.6)(H) * 0.01),
        "W2": _w((lambda *s: torch.randn(*s, dtype=torch.bfloat16) * 1.6)(H) * (1.0 / H) ** 0.5),
        "b2": _w((lambda *s: torch.randn(*s, dtype=torch.bfloat16) * 1.6)(1) * 0.01),
    }

def reference(idx, table, x_wide, w_wide, b_wide, W1, b1, W2, b2):
    emb = table[idx]
    deep_in = emb.reshape(emb.shape[0], -1)
    h = deep_in @ W1 + b1
    h = h * (lambda x, dt: x.to(dt))(h > 0, h.dtype)
    deep_logit = h @ W2 + b2
    wide_logit = x_wide @ w_wide + b_wide
    return _sigmoid(wide_logit + deep_logit)
```

```asm
; @launch grid=(256,1,1) block=(512,1,1) lds=146432
.amdgcn_target "amdgcn-amd-amdhsa--gfx950"
.text
.globl standalone__deep_cross_wide_deep__recsys_kernel
.p2align 8
.type standalone__deep_cross_wide_deep__recsys_kernel,@function
standalone__deep_cross_wide_deep__recsys_kernel:
  s_cmp_ge_u32 s2, 256
  s_cbranch_scc1 L_end
  s_load_dwordx16 s[4:19], s[0:1], 0
  s_load_dwordx8 s[20:27], s[0:1], 64
  v_lshrrev_b32 v1, 6, v0
  v_and_b32 v0, 63, v0
  s_and_b32 s58, s2, 1
  v_readfirstlane_b32 s3, v1
  s_bfe_u32 s56, s2, 0x20001
  s_lshl_b32 s56, s56, 3
  s_lshr_b32 s59, s2, 5
  s_add_u32 s56, s56, s59
  s_bfe_u32 s57, s2, 0x20003
  s_cmp_lt_u32 s3, 4
  s_cbranch_scc1 L_compute
  s_sub_u32 s59, s3, 4
  v_lshlrev_b32 v17, 4, v0
  s_mul_i32 s63, s59, 3328
  s_add_u32 s63, s63, 131072
  s_mov_b32 m0, s63
  s_lshl_b32 s61, s56, 7
  s_lshl_b32 s62, s59, 5
  s_add_u32 s61, s61, s62
  s_mul_i32 s61, s61, 104
  s_mov_b32 s38, 425984
  s_mov_b32 s39, 0x00020000
  v_lshrrev_b32 v19, 4, v0
  v_and_b32 v18, 15, v0
  v_lshlrev_b32 v20, 1, v19
  v_xor_b32 v18, v18, v20
  v_lshlrev_b32 v18, 4, v18
  v_lshl_add_u32 v18, v19, 10, v18
  s_lshl_b32 s76, s59, 14
  s_lshl_b32 s62, s57, 8
  s_add_u32 s76, s76, s62
  v_add_u32 v8, s76, v18
  v_add_u32 v9, 4096, v8
  v_xor_b32 v10, 128, v8
  v_add_u32 v10, 8192, v10
  v_add_u32 v11, 4096, v10
  s_lshl_b32 s77, s59, 12
  s_lshr_b32 s76, s2, 5
  s_add_u32 s76, s76, s57
  s_and_b32 s76, s76, 3
  s_cmp_lg_u32 s76, 0
  s_cbranch_scc1 L_tab1
  s_mov_b32 s80, 0x3020100
  s_mov_b32 s81, 0x6050407
  s_mov_b32 s82, 0xa09080b
  s_mov_b32 s83, 0xe0d0c0f
  s_mov_b32 s84, 0x12111013
  s_mov_b32 s85, 0x16151417
  s_mov_b32 s86, 0x19191918
  s_branch L_tabdone
L_tab1:
  s_cmp_lg_u32 s76, 1
  s_cbranch_scc1 L_tab2
  s_mov_b32 s80, 0x2000401
  s_mov_b32 s81, 0x6050803
  s_mov_b32 s82, 0xa090c07
  s_mov_b32 s83, 0xe0d100b
  s_mov_b32 s84, 0x1211140f
  s_mov_b32 s85, 0x16151813
  s_mov_b32 s86, 0x19191917
  s_branch L_tabdone
L_tab2:
  s_cmp_lg_u32 s76, 2
  s_cbranch_scc1 L_tab3
  s_mov_b32 s80, 0x1050002
  s_mov_b32 s81, 0x6090403
  s_mov_b32 s82, 0xa0d0807
  s_mov_b32 s83, 0xe110c0b
  s_mov_b32 s84, 0x1215100f
  s_mov_b32 s85, 0x16191413
  s_mov_b32 s86, 0x19191817
  s_branch L_tabdone
L_tab3:
  s_mov_b32 s80, 0x6010003
  s_mov_b32 s81, 0xa050402
  s_mov_b32 s82, 0xe090807
  s_mov_b32 s83, 0x120d0c0b
  s_mov_b32 s84, 0x1611100f
  s_mov_b32 s85, 0x17151413
  s_mov_b32 s86, 0x19191918
L_tabdone:
  s_bfe_u32 s87, s80, 0x80000
  s_bfe_u32 s88, s80, 0x80008
  s_bfe_u32 s89, s80, 0x80010
  s_bfe_u32 s90, s80, 0x80018
  s_and_b32 s79, s81, 0xff
  s_mov_b32 s78, 5
  s_mov_b32 s34, 3407872
  s_mov_b32 s35, 0x00020000
  s_waitcnt lgkmcnt(0)
  s_mov_b32 s36, s4
  s_and_b32 s37, s5, 0xffff
  buffer_load_dwordx4 v17, s[36:39], s61 offen offset:0 lds
  buffer_load_dwordx4 v17, s[36:39], s61 offen offset:1024 lds
  buffer_load_dwordx4 v17, s[36:39], s61 offen offset:2048 lds
  s_mov_b64 exec, 0xffff
  buffer_load_dwordx4 v17, s[36:39], s61 offen offset:3072 lds
  s_mov_b64 exec, -1
  s_mov_b32 s32, s14
  s_and_b32 s33, s15, 0xffff
  s_mul_i32 s61, s58, 1703936
  s_lshl_b32 s91, s87, 16
  s_add_u32 s91, s91, s61
  s_add_u32 m0, s77, 16384
  s_nop 0
  buffer_load_dwordx4 v8, s[32:35], s91 offen lds
  s_add_u32 m0, s77, 17408
  s_nop 0
  buffer_load_dwordx4 v9, s[32:35], s91 offen lds
  s_add_u32 m0, s77, 18432
  s_nop 0
  buffer_load_dwordx4 v10, s[32:35], s91 offen lds
  s_add_u32 m0, s77, 19456
  s_nop 0
  buffer_load_dwordx4 v11, s[32:35], s91 offen lds
  s_lshl_b32 s91, s88, 16
  s_add_u32 s91, s91, s61
  s_add_u32 m0, s77, 49152
  s_nop 0
  buffer_load_dwordx4 v8, s[32:35], s91 offen lds
  s_add_u32 m0, s77, 50176
  s_nop 0
  buffer_load_dwordx4 v9, s[32:35], s91 offen lds
  s_add_u32 m0, s77, 51200
  s_nop 0
  buffer_load_dwordx4 v10, s[32:35], s91 offen lds
  s_add_u32 m0, s77, 52224
  s_nop 0
  buffer_load_dwordx4 v11, s[32:35], s91 offen lds
  s_mov_b32 s28, s6
  s_and_b32 s29, s7, 0xffff
  s_mov_b32 s30, 25600000
  s_mov_b32 s31, 0x00020000
  s_load_dwordx8 s[64:71], s[10:11], 0
  s_load_dword s72, s[12:13], 0
  s_load_dword s73, s[20:21], 0
  v_and_b32 v18, 7, v0
  v_xor_b32 v20, v18, v19
  v_lshlrev_b32 v6, 4, v20
  v_xor_b32 v7, 64, v6
  v_lshrrev_b32 v20, 3, v0
  v_mul_u32_u24 v12, 104, v20
  s_mul_i32 s62, s58, 52
  s_add_u32 s63, s63, s62
  v_add_u32 v12, s63, v12
  s_mov_b32 s63, s77
  s_lshr_b32 s76, s87, 1
  s_lshl_b32 s76, s76, 2
  v_add_u32 v24, s76, v12
  s_lshr_b32 s76, s88, 1
  s_lshl_b32 s76, s76, 2
  v_add_u32 v25, s76, v12
  s_lshr_b32 s76, s89, 1
  s_lshl_b32 s76, s76, 2
  v_add_u32 v26, s76, v12
  s_lshr_b32 s76, s90, 1
  s_lshl_b32 s76, s76, 2
  v_add_u32 v27, s76, v12
  s_lshr_b32 s76, s79, 1
  s_lshl_b32 s76, s76, 2
  v_add_u32 v28, s76, v12
  s_waitcnt vmcnt(8) lgkmcnt(0)
  ds_read_b32 v32, v24 offset:0
  ds_read_b32 v33, v24 offset:832
  ds_read_b32 v34, v24 offset:1664
  ds_read_b32 v35, v24 offset:2496
  ds_read_b32 v36, v25 offset:0
  ds_read_b32 v37, v25 offset:832
  ds_read_b32 v38, v25 offset:1664
  ds_read_b32 v39, v25 offset:2496
  ds_read_b32 v40, v26 offset:0
  ds_read_b32 v41, v26 offset:832
  ds_read_b32 v42, v26 offset:1664
  ds_read_b32 v43, v26 offset:2496
  ds_read_b32 v44, v27 offset:0
  ds_read_b32 v45, v27 offset:832
  ds_read_b32 v46, v27 offset:1664
  ds_read_b32 v47, v27 offset:2496
  ds_read_b32 v48, v28 offset:0
  ds_read_b32 v49, v28 offset:832
  ds_read_b32 v50, v28 offset:1664
  ds_read_b32 v51, v28 offset:2496
  s_and_b32 s92, s87, 1
  s_lshl_b32 s92, s92, 7
  s_waitcnt lgkmcnt(15)
  v_lshl_add_u32 v2, v32, 8, v6
  v_lshl_add_u32 v3, v33, 8, v7
  v_lshl_add_u32 v4, v34, 8, v6
  v_lshl_add_u32 v5, v35, 8, v7
  s_add_u32 m0, s63, 0
  s_nop 0
  buffer_load_dwordx4 v2, s[28:31], s92 offen lds
  s_add_u32 m0, s63, 1024
  s_nop 0
  buffer_load_dwordx4 v3, s[28:31], s92 offen lds
  s_add_u32 m0, s63, 2048
  s_nop 0
  buffer_load_dwordx4 v4, s[28:31], s92 offen lds
  s_add_u32 m0, s63, 3072
  s_nop 0
  buffer_load_dwordx4 v5, s[28:31], s92 offen lds
  s_and_b32 s92, s88, 1
  s_lshl_b32 s92, s92, 7
  s_waitcnt lgkmcnt(12)
  v_lshl_add_u32 v2, v36, 8, v6
  v_lshl_add_u32 v3, v37, 8, v7
  v_lshl_add_u32 v4, v38, 8, v6
  v_lshl_add_u32 v5, v39, 8, v7
  s_add_u32 m0, s63, 32768
  s_nop 0
  buffer_load_dwordx4 v2, s[28:31], s92 offen lds
  s_add_u32 m0, s63, 33792
  s_nop 0
  buffer_load_dwordx4 v3, s[28:31], s92 offen lds
  s_add_u32 m0, s63, 34816
  s_nop 0
  buffer_load_dwordx4 v4, s[28:31], s92 offen lds
  s_add_u32 m0, s63, 35840
  s_nop 0
  buffer_load_dwordx4 v5, s[28:31], s92 offen lds
  s_lshl_b32 s91, s89, 16
  s_add_u32 s91, s91, s61
  s_add_u32 m0, s77, 81920
  s_nop 0
  buffer_load_dwordx4 v8, s[32:35], s91 offen lds
  s_add_u32 m0, s77, 82944
  s_nop 0
  buffer_load_dwordx4 v9, s[32:35], s91 offen lds
  s_add_u32 m0, s77, 83968
  s_nop 0
  buffer_load_dwordx4 v10, s[32:35], s91 offen lds
  s_add_u32 m0, s77, 84992
  s_nop 0
  buffer_load_dwordx4 v11, s[32:35], s91 offen lds
  s_and_b32 s92, s89, 1
  s_lshl_b32 s92, s92, 7
  s_waitcnt lgkmcnt(8)
  v_lshl_add_u32 v2, v40, 8, v6
  v_lshl_add_u32 v3, v41, 8, v7
  v_lshl_add_u32 v4, v42, 8, v6
  v_lshl_add_u32 v5, v43, 8, v7
  s_add_u32 m0, s63, 65536
  s_nop 0
  buffer_load_dwordx4 v2, s[28:31], s92 offen lds
  s_add_u32 m0, s63, 66560
  s_nop 0
  buffer_load_dwordx4 v3, s[28:31], s92 offen lds
  s_add_u32 m0, s63, 67584
  s_nop 0
  buffer_load_dwordx4 v4, s[28:31], s92 offen lds
  s_add_u32 m0, s63, 68608
  s_nop 0
  buffer_load_dwordx4 v5, s[28:31], s92 offen lds
  s_lshl_b32 s91, s90, 16
  s_add_u32 s91, s91, s61
  s_add_u32 m0, s77, 114688
  s_nop 0
  buffer_load_dwordx4 v8, s[32:35], s91 offen lds
  s_add_u32 m0, s77, 115712
  s_nop 0
  buffer_load_dwordx4 v9, s[32:35], s91 offen lds
  s_add_u32 m0, s77, 116736
  s_nop 0
  buffer_load_dwordx4 v10, s[32:35], s91 offen lds
  s_add_u32 m0, s77, 117760
  s_nop 0
  buffer_load_dwordx4 v11, s[32:35], s91 offen lds
  s_and_b32 s92, s90, 1
  s_lshl_b32 s92, s92, 7
  s_waitcnt lgkmcnt(4)
  v_lshl_add_u32 v2, v44, 8, v6
  v_lshl_add_u32 v3, v45, 8, v7
  v_lshl_add_u32 v4, v46, 8, v6
  v_lshl_add_u32 v5, v47, 8, v7
  s_add_u32 m0, s63, 98304
  s_nop 0
  buffer_load_dwordx4 v2, s[28:31], s92 offen lds
  s_add_u32 m0, s63, 99328
  s_nop 0
  buffer_load_dwordx4 v3, s[28:31], s92 offen lds
  s_add_u32 m0, s63, 100352
  s_nop 0
  buffer_load_dwordx4 v4, s[28:31], s92 offen lds
  s_add_u32 m0, s63, 101376
  s_nop 0
  buffer_load_dwordx4 v5, s[28:31], s92 offen lds
  s_waitcnt lgkmcnt(0)
  v_lshl_add_u32 v2, v48, 8, v6
  v_lshl_add_u32 v3, v49, 8, v7
  v_lshl_add_u32 v4, v50, 8, v6
  v_lshl_add_u32 v5, v51, 8, v7
  s_and_b32 s92, s79, 1
  s_lshl_b32 s92, s92, 7
  s_lshl_b32 s91, s79, 16
  s_add_u32 s91, s91, s61
  s_mov_b32 s60, 0
  s_mov_b32 s75, 0
  s_waitcnt vmcnt(20)
  s_barrier
  .p2align 3
L_l_loop:
  s_waitcnt vmcnt(16)
  s_barrier
  s_add_u32 s76, s60, s63
  s_mov_b32 m0, s76
  s_nop 0
  buffer_load_dwordx4 v2, s[28:31], s92 offen lds
  s_add_u32 m0, s76, 1024
  s_nop 0
  buffer_load_dwordx4 v3, s[28:31], s92 offen lds
  s_add_u32 m0, s76, 2048
  s_nop 0
  buffer_load_dwordx4 v4, s[28:31], s92 offen lds
  s_add_u32 m0, s76, 3072
  s_nop 0
  buffer_load_dwordx4 v5, s[28:31], s92 offen lds
  s_add_u32 m0, s76, 16384
  s_nop 0
  buffer_load_dwordx4 v8, s[32:35], s91 offen lds
  s_add_u32 m0, s76, 17408
  s_nop 0
  buffer_load_dwordx4 v9, s[32:35], s91 offen lds
  s_add_u32 m0, s76, 18432
  s_nop 0
  buffer_load_dwordx4 v10, s[32:35], s91 offen lds
  s_add_u32 m0, s76, 19456
  s_nop 0
  buffer_load_dwordx4 v11, s[32:35], s91 offen lds
  s_add_u32 s60, s60, 32768
  s_and_b32 s60, s60, 131071
  s_lshr_b32 m0, s78, 2
  s_and_b32 s76, s78, 3
  s_lshl_b32 s76, s76, 3
  s_movrels_b32 s79, s80
  s_lshr_b32 s79, s79, s76
  s_and_b32 s79, s79, 0xff
  s_add_u32 s78, s78, 1
  s_lshr_b32 s76, s79, 1
  s_lshl_b32 s76, s76, 2
  v_add_u32 v24, s76, v12
  ds_read_b32 v13, v24 offset:0
  ds_read_b32 v14, v24 offset:832
  ds_read_b32 v15, v24 offset:1664
  ds_read_b32 v16, v24 offset:2496
  s_and_b32 s92, s79, 1
  s_lshl_b32 s92, s92, 7
  s_lshl_b32 s91, s79, 16
  s_add_u32 s91, s91, s61
  s_add_u32 s75, s75, 1
  s_waitcnt lgkmcnt(0)
  v_lshl_add_u32 v2, v13, 8, v6
  v_lshl_add_u32 v3, v14, 8, v7
  v_lshl_add_u32 v4, v15, 8, v6
  v_lshl_add_u32 v5, v16, 8, v7
  s_cmp_lt_u32 s75, 22
  s_cbranch_scc1 L_l_loop
  s_mov_b32 s40, s8
  s_and_b32 s41, s9, 0xffff
  s_mov_b32 s42, 106496
  s_mov_b32 s43, 0x00020000
  s_mov_b32 s44, s26
  s_and_b32 s45, s27, 0xffff
  s_mov_b32 s46, 9437184
  s_mov_b32 s47, 0x00020000
  s_mov_b32 s48, s24
  s_and_b32 s49, s25, 0xffff
  s_mov_b32 s50, 256
  s_mov_b32 s51, 0x00020000
  s_mov_b32 s52, s22
  s_and_b32 s53, s23, 0xffff
  s_mov_b32 s54, 8192
  s_mov_b32 s55, 0x00020000
  v_lshrrev_b32 v18, 5, v0
  v_lshlrev_b32 v18, 6, v18
  v_and_b32 v19, 31, v0
  v_add_u32 v18, v18, v19
  s_lshl_b32 s76, s56, 7
  s_lshl_b32 s77, s58, 5
  s_add_u32 s76, s76, s77
  v_add_u32 v22, s76, v18
  v_mul_u32_u24 v18, 26, v22
  v_and_b32 v18, 0xfffffffc, v18
  v_and_b32 v23, 1, v0
  v_lshlrev_b32 v23, 4, v23
  s_lshl_b32 s76, s56, 1
  s_add_u32 s76, s76, s58
  s_lshl_b32 s77, s76, 2
  v_mov_b32 v47, s77
  s_waitcnt vmcnt(16)
  s_barrier
  s_waitcnt vmcnt(8)
  s_barrier
  s_waitcnt vmcnt(0)
  s_barrier
  s_cmp_lg_u32 s59, 0
  s_cbranch_scc1 L_l_done
  buffer_load_dwordx4 v[32:35], v18, s[40:43], 0 offen
  buffer_load_dwordx3 v[36:38], v18, s[40:43], 0 offen offset:16
  buffer_load_dword v46, v47, s[48:51], 0 offen sc0 sc1
  s_lshl_b32 s78, s64, 16
  s_and_b32 s79, s64, 0xffff0000
  s_lshl_b32 s80, s65, 16
  s_and_b32 s81, s65, 0xffff0000
  s_lshl_b32 s82, s66, 16
  s_and_b32 s83, s66, 0xffff0000
  s_lshl_b32 s84, s67, 16
  s_and_b32 s85, s67, 0xffff0000
  s_lshl_b32 s86, s68, 16
  s_and_b32 s87, s68, 0xffff0000
  s_lshl_b32 s88, s69, 16
  s_and_b32 s89, s69, 0xffff0000
  s_lshl_b32 s90, s70, 16
  s_lshl_b32 s72, s72, 16
  s_lshl_b32 s73, s73, 16
  v_mov_b32 v48, 0
  s_waitcnt vmcnt(1)
  v_alignbit_b32 v18, v33, v32, v23
  v_lshlrev_b32 v19, 16, v18
  v_fmac_f32 v48, s78, v19
  v_and_b32 v19, 0xffff0000, v18
  v_fmac_f32 v48, s79, v19
  v_alignbit_b32 v18, v34, v33, v23
  v_lshlrev_b32 v19, 16, v18
  v_fmac_f32 v48, s80, v19
  v_and_b32 v19, 0xffff0000, v18
  v_fmac_f32 v48, s81, v19
  v_alignbit_b32 v18, v35, v34, v23
  v_lshlrev_b32 v19, 16, v18
  v_fmac_f32 v48, s82, v19
  v_and_b32 v19, 0xffff0000, v18
  v_fmac_f32 v48, s83, v19
  v_alignbit_b32 v18, v36, v35, v23
  v_lshlrev_b32 v19, 16, v18
  v_fmac_f32 v48, s84, v19
  v_and_b32 v19, 0xffff0000, v18
  v_fmac_f32 v48, s85, v19
  v_alignbit_b32 v18, v37, v36, v23
  v_lshlrev_b32 v19, 16, v18
  v_fmac_f32 v48, s86, v19
  v_and_b32 v19, 0xffff0000, v18
  v_fmac_f32 v48, s87, v19
  v_alignbit_b32 v18, v38, v37, v23
  v_lshlrev_b32 v19, 16, v18
  v_fmac_f32 v48, s88, v19
  v_and_b32 v19, 0xffff0000, v18
  v_fmac_f32 v48, s89, v19
  v_lshrrev_b32 v18, v23, v38
  v_lshlrev_b32 v19, 16, v18
  v_fmac_f32 v48, s90, v19
  v_cvt_pk_bf16_f32 v48, v48, v48
  v_lshlrev_b32 v48, 16, v48
  v_add_f32 v48, s72, v48
  v_cvt_pk_bf16_f32 v48, v48, v48
  v_lshlrev_b32 v48, 16, v48
  s_lshl_b32 s76, s76, 10
  v_lshlrev_b32 v51, 2, v0
  v_add_u32 v18, 144384, v51
  v_add_u32 v51, s76, v51
  s_lshl_b32 s76, s57, 8
  v_add_u32 v50, s76, v51
  v_mov_b32 v19, 0x7fc00000
  v_lshlrev_b32 v22, 1, v22
  s_mov_b32 s77, 0x01010101
  s_barrier
  ds_read_b32 v52, v18 offset:0
  ds_read_b32 v53, v18 offset:256
  ds_read_b32 v54, v18 offset:512
  ds_read_b32 v55, v18 offset:768
  ds_read_b32 v56, v18 offset:1024
  ds_read_b32 v57, v18 offset:1280
  ds_read_b32 v58, v18 offset:1536
  ds_read_b32 v59, v18 offset:1792
  s_waitcnt lgkmcnt(0)
  v_add_f32 v52, v52, v53
  v_add_f32 v54, v54, v55
  v_add_f32 v56, v56, v57
  v_add_f32 v58, v58, v59
  v_add_f32 v52, v52, v54
  v_add_f32 v56, v56, v58
  v_add_f32 v52, v52, v56
  v_cmp_eq_u32 vcc, -1, v52
  s_nop 1
  v_cndmask_b32 v52, v52, v19, vcc
  buffer_store_dword v52, v50, s[44:47], 0 offen sc0 sc1
  s_waitcnt vmcnt(0)
  v_readfirstlane_b32 s76, v46
  s_nop 3
  s_cmp_eq_u32 s76, s77
  s_cbranch_scc1 L_l_flags_ok
  buffer_load_dword v46, v47, s[48:51], 0 offen sc0 sc1
  s_waitcnt vmcnt(0)
  v_readfirstlane_b32 s76, v46
  s_nop 3
  s_cmp_eq_u32 s76, s77
  s_cbranch_scc0 L_fin_exit
L_l_flags_ok:
  buffer_load_dword v60, v51, s[44:47], 0 offen offset:0 sc0 sc1
  buffer_load_dword v61, v51, s[44:47], 0 offen offset:256 sc0 sc1
  buffer_load_dword v62, v51, s[44:47], 0 offen offset:512 sc0 sc1
  buffer_load_dword v63, v51, s[44:47], 0 offen offset:768 sc0 sc1
  s_waitcnt vmcnt(0)
  v_max3_u32 v18, v60, v61, v62
  v_max_u32 v18, v18, v63
  v_cmp_eq_u32 vcc, -1, v18
  v_add_f32 v60, v60, v61
  v_add_f32 v62, v62, v63
  s_cmp_lg_u64 vcc, 0
  s_cbranch_scc1 L_fin_exit
  v_add_f32 v60, v60, v62
  v_cvt_pk_bf16_f32 v60, v60, v60
  v_lshlrev_b32 v60, 16, v60
  v_add_f32 v60, s73, v60
  v_cvt_pk_bf16_f32 v60, v60, v60
  v_lshlrev_b32 v60, 16, v60
  v_add_f32 v60, v48, v60
  v_cvt_pk_bf16_f32 v60, v60, v60
  v_lshlrev_b32 v60, 16, v60
  v_mul_f32 v60, 0xbfb8aa3b, v60
  v_exp_f32 v60, v60
  s_nop 0
  v_add_f32 v60, 1.0, v60
  v_rcp_f32 v60, v60
  s_nop 0
  v_cvt_pk_bf16_f32 v18, v60, v60
  buffer_store_short v18, v22, s[52:55], 0 offen
L_fin_exit:
  s_endpgm
L_l_done:
  s_barrier
L_end:
  s_endpgm
  .p2align 6
L_compute:
  s_lshr_b32 s59, s3, 1
  s_and_b32 s60, s3, 1
  v_and_b32 v18, 15, v0
  v_lshlrev_b32 v18, 7, v18
  s_lshl_b32 s63, s59, 13
  s_lshl_b32 s64, s58, 12
  s_add_u32 s63, s63, s64
  v_add_u32 v18, s63, v18
  v_lshrrev_b32 v19, 4, v0
  v_bfe_u32 v20, v0, 1, 3
  v_xor_b32 v20, v19, v20
  v_lshl_add_u32 v2, v20, 4, v18
  v_xor_b32 v3, 64, v2
  v_xor_b32 v4, 0x1000, v2
  v_xor_b32 v5, 0x1000, v3
  v_bfe_u32 v20, v0, 2, 2
  v_lshl_add_u32 v18, v19, 3, v20
  v_lshlrev_b32 v18, 8, v18
  v_and_b32 v21, 1, v19
  v_lshl_or_b32 v20, v21, 2, v20
  v_lshlrev_b32 v20, 1, v20
  v_bfe_u32 v21, v0, 1, 1
  s_lshl_b32 s63, s60, 3
  v_or_b32 v21, s63, v21
  v_xor_b32 v21, v21, v20
  v_lshl_add_u32 v18, v21, 4, v18
  v_and_b32 v21, 1, v0
  v_lshl_add_u32 v18, v21, 3, v18
  v_add_u32 v6, 16384, v18
  v_xor_b32 v7, 32, v6
  v_xor_b32 v8, 64, v6
  v_xor_b32 v9, 96, v6
  s_lshl_b32 s63, s2, 15
  s_lshl_b32 s64, s3, 13
  s_add_u32 s63, s63, s64
  s_add_u32 s63, s63, 1048576
  v_lshlrev_b32 v22, 4, v0
  v_add_u32 v22, s63, v22
  s_lshl_b32 s63, s2, 9
  s_lshl_b32 s64, s3, 7
  s_add_u32 s63, s63, s64
  s_add_u32 s63, s63, 65536
  v_mov_b32 v24, s63
  s_lshl_b32 s63, s56, 3
  v_mov_b32 v23, s63
  v_mov_b32 v20, 0
  v_mov_b32 v21, -1
  v_mov_b32 v32, 0
  v_mov_b32 v33, 0
  v_mov_b32 v34, 0
  v_mov_b32 v35, 0
  v_mov_b32 v36, 0
  v_mov_b32 v37, 0
  v_mov_b32 v38, 0
  v_mov_b32 v39, 0
  v_mov_b32 v40, 0
  v_mov_b32 v41, 0
  v_mov_b32 v42, 0
  v_mov_b32 v43, 0
  v_mov_b32 v44, 0
  v_mov_b32 v45, 0
  v_mov_b32 v46, 0
  v_mov_b32 v47, 0
  v_mov_b32 v48, 0
  v_mov_b32 v49, 0
  v_mov_b32 v50, 0
  v_mov_b32 v51, 0
  v_mov_b32 v52, 0
  v_mov_b32 v53, 0
  v_mov_b32 v54, 0
  v_mov_b32 v55, 0
  v_mov_b32 v56, 0
  v_mov_b32 v57, 0
  v_mov_b32 v58, 0
  v_mov_b32 v59, 0
  v_mov_b32 v60, 0
  v_mov_b32 v61, 0
  v_mov_b32 v62, 0
  v_mov_b32 v63, 0
  v_mov_b32 v64, 0
  v_mov_b32 v65, 0
  v_mov_b32 v66, 0
  v_mov_b32 v67, 0
  v_mov_b32 v68, 0
  v_mov_b32 v69, 0
  v_mov_b32 v70, 0
  v_mov_b32 v71, 0
  v_mov_b32 v72, 0
  v_mov_b32 v73, 0
  v_mov_b32 v74, 0
  v_mov_b32 v75, 0
  v_mov_b32 v76, 0
  v_mov_b32 v77, 0
  v_mov_b32 v78, 0
  v_mov_b32 v79, 0
  v_mov_b32 v80, 0
  v_mov_b32 v81, 0
  v_mov_b32 v82, 0
  v_mov_b32 v83, 0
  v_mov_b32 v84, 0
  v_mov_b32 v85, 0
  v_mov_b32 v86, 0
  v_mov_b32 v87, 0
  v_mov_b32 v88, 0
  v_mov_b32 v89, 0
  v_mov_b32 v90, 0
  v_mov_b32 v91, 0
  v_mov_b32 v92, 0
  v_mov_b32 v93, 0
  v_mov_b32 v94, 0
  v_mov_b32 v95, 0
  s_waitcnt lgkmcnt(0)
  s_mov_b32 s44, s26
  s_and_b32 s45, s27, 0xffff
  s_mov_b32 s46, 9437184
  s_mov_b32 s47, 0x00020000
  s_mov_b32 s48, s24
  s_and_b32 s49, s25, 0xffff
  s_mov_b32 s50, 256
  s_mov_b32 s51, 0x00020000
  s_mov_b32 s40, s16
  s_and_b32 s41, s17, 0xffff
  s_mov_b32 s42, 1024
  s_mov_b32 s43, 0x00020000
  s_mov_b32 s36, s18
  s_and_b32 s37, s19, 0xffff
  s_mov_b32 s38, 1024
  s_mov_b32 s39, 0x00020000
  s_mov_b64 exec, 1
  buffer_store_dword v20, v24, s[44:47], 0 offen sc0 sc1
  s_mov_b64 exec, -1
  s_cmp_lg_u32 s3, 0
  s_cbranch_scc1 L_c_p0
  s_lshl_b32 s63, s56, 1
  s_add_u32 s63, s63, s58
  s_lshl_b32 s63, s63, 2
  s_add_u32 s63, s63, s57
  s_lshl_b32 s63, s63, 8
  v_lshlrev_b32 v18, 2, v0
  buffer_store_dword v21, v18, s[44:47], s63 offen sc0 sc1
L_c_p0:
  v_lshlrev_b32 v18, 3, v19
  s_lshl_b32 s63, s57, 8
  s_lshl_b32 s64, s60, 7
  s_add_u32 s63, s63, s64
  buffer_load_dwordx2 v[226:227], v18, s[40:43], s63 offen offset:0
  buffer_load_dwordx2 v[234:235], v18, s[36:39], s63 offen offset:0
  buffer_load_dwordx2 v[228:229], v18, s[40:43], s63 offen offset:32
  buffer_load_dwordx2 v[236:237], v18, s[36:39], s63 offen offset:32
  buffer_load_dwordx2 v[230:231], v18, s[40:43], s63 offen offset:64
  buffer_load_dwordx2 v[238:239], v18, s[36:39], s63 offen offset:64
  buffer_load_dwordx2 v[232:233], v18, s[40:43], s63 offen offset:96
  buffer_load_dwordx2 v[240:241], v18, s[36:39], s63 offen offset:96
  s_setprio 1
  s_mov_b32 s61, 0
  v_mov_b32 v10, v2
  v_mov_b32 v11, v3
  v_mov_b32 v12, v4
  v_mov_b32 v13, v5
  v_mov_b32 v14, v6
  v_mov_b32 v15, v7
  v_mov_b32 v16, v8
  v_mov_b32 v17, v9
  s_waitcnt vmcnt(0)
  s_barrier
  ds_read_b128 v[96:99], v10 offset:0
  ds_read_b64_tr_b16 v[128:129], v14 offset:0
  ds_read_b64_tr_b16 v[130:131], v14 offset:1024
  ds_read_b128 v[100:103], v10 offset:2048
  ds_read_b64_tr_b16 v[132:133], v15 offset:0
  ds_read_b64_tr_b16 v[134:135], v15 offset:1024
  ds_read_b128 v[104:107], v12 offset:0
  ds_read_b64_tr_b16 v[136:137], v16 offset:0
  ds_read_b64_tr_b16 v[138:139], v16 offset:1024
  ds_read_b128 v[108:111], v12 offset:2048
  ds_read_b64_tr_b16 v[140:141], v17 offset:0
  ds_read_b64_tr_b16 v[142:143], v17 offset:1024
  ds_read_b128 v[112:115], v11 offset:0
  ds_read_b64_tr_b16 v[144:145], v14 offset:8192
  ds_read_b64_tr_b16 v[146:147], v14 offset:9216
  ds_read_b128 v[116:119], v11 offset:2048
  ds_read_b64_tr_b16 v[148:149], v15 offset:8192
  ds_read_b64_tr_b16 v[150:151], v15 offset:9216
  ds_read_b128 v[120:123], v13 offset:0
  ds_read_b64_tr_b16 v[152:153], v16 offset:8192
  ds_read_b64_tr_b16 v[154:155], v16 offset:9216
  ds_read_b128 v[124:127], v13 offset:2048
  ds_read_b64_tr_b16 v[156:157], v17 offset:8192
  ds_read_b64_tr_b16 v[158:159], v17 offset:9216
  s_add_u32 s61, s61, 32768
  s_and_b32 s61, s61, 131071
  v_add_u32 v10, s61, v2
  v_add_u32 v11, s61, v3
  v_add_u32 v12, s61, v4
  v_add_u32 v13, s61, v5
  v_add_u32 v14, s61, v6
  v_add_u32 v15, s61, v7
  v_add_u32 v16, s61, v8
  v_add_u32 v17, s61, v9
  s_cmp_lg_u32 s3, 0
  s_cbranch_scc1 L_c_p5
  s_lshl_b32 s63, s57, 3
  s_lshl_b32 s63, 1, s63
  v_mov_b32 v18, s63
  s_lshl_b32 s63, s58, 2
  s_mov_b64 exec, 1
  buffer_atomic_or v18, v23, s[48:51], s63 offen
  s_mov_b64 exec, -1
L_c_p5:
  s_mov_b32 s62, 0
  .p2align 3
L_c_loop:
  s_waitcnt lgkmcnt(0)
  s_barrier
  ds_read_b128 v[160:163], v10 offset:0
  v_mfma_f32_16x16x32_bf16 v[32:35], v[128:131], v[96:99], v[32:35]
  ds_read_b64_tr_b16 v[192:193], v14 offset:0
  v_mfma_f32_16x16x32_bf16 v[36:39], v[128:131], v[100:103], v[36:39]
  ds_read_b64_tr_b16 v[194:195], v14 offset:1024
  v_mfma_f32_16x16x32_bf16 v[40:43], v[128:131], v[104:107], v[40:43]
  ds_read_b128 v[164:167], v10 offset:2048
  v_mfma_f32_16x16x32_bf16 v[44:47], v[128:131], v[108:111], v[44:47]
  ds_read_b64_tr_b16 v[196:197], v15 offset:0
  v_mfma_f32_16x16x32_bf16 v[48:51], v[132:135], v[96:99], v[48:51]
  ds_read_b64_tr_b16 v[198:199], v15 offset:1024
  v_mfma_f32_16x16x32_bf16 v[52:55], v[132:135], v[100:103], v[52:55]
  ds_read_b128 v[168:171], v12 offset:0
  v_mfma_f32_16x16x32_bf16 v[56:59], v[132:135], v[104:107], v[56:59]
  ds_read_b64_tr_b16 v[200:201], v16 offset:0
  v_mfma_f32_16x16x32_bf16 v[60:63], v[132:135], v[108:111], v[60:63]
  ds_read_b64_tr_b16 v[202:203], v16 offset:1024
  v_mfma_f32_16x16x32_bf16 v[64:67], v[136:139], v[96:99], v[64:67]
  ds_read_b128 v[172:175], v12 offset:2048
  v_mfma_f32_16x16x32_bf16 v[68:71], v[136:139], v[100:103], v[68:71]
  ds_read_b64_tr_b16 v[204:205], v17 offset:0
  v_mfma_f32_16x16x32_bf16 v[72:75], v[136:139], v[104:107], v[72:75]
  ds_read_b64_tr_b16 v[206:207], v17 offset:1024
  v_mfma_f32_16x16x32_bf16 v[76:79], v[136:139], v[108:111], v[76:79]
  ds_read_b128 v[176:179], v11 offset:0
  v_mfma_f32_16x16x32_bf16 v[80:83], v[140:143], v[96:99], v[80:83]
  ds_read_b64_tr_b16 v[208:209], v14 offset:8192
  v_mfma_f32_16x16x32_bf16 v[84:87], v[140:143], v[100:103], v[84:87]
  ds_read_b64_tr_b16 v[210:211], v14 offset:9216
  v_mfma_f32_16x16x32_bf16 v[88:91], v[140:143], v[104:107], v[88:91]
  ds_read_b128 v[180:183], v11 offset:2048
  v_mfma_f32_16x16x32_bf16 v[92:95], v[140:143], v[108:111], v[92:95]
  ds_read_b64_tr_b16 v[212:213], v15 offset:8192
  v_mfma_f32_16x16x32_bf16 v[32:35], v[144:147], v[112:115], v[32:35]
  ds_read_b64_tr_b16 v[214:215], v15 offset:9216
  v_mfma_f32_16x16x32_bf16 v[36:39], v[144:147], v[116:119], v[36:39]
  ds_read_b128 v[184:187], v13 offset:0
  v_mfma_f32_16x16x32_bf16 v[40:43], v[144:147], v[120:123], v[40:43]
  ds_read_b64_tr_b16 v[216:217], v16 offset:8192
  v_mfma_f32_16x16x32_bf16 v[44:47], v[144:147], v[124:127], v[44:47]
  ds_read_b64_tr_b16 v[218:219], v16 offset:9216
  v_mfma_f32_16x16x32_bf16 v[48:51], v[148:151], v[112:115], v[48:51]
  ds_read_b128 v[188:191], v13 offset:2048
  v_mfma_f32_16x16x32_bf16 v[52:55], v[148:151], v[116:119], v[52:55]
  ds_read_b64_tr_b16 v[220:221], v17 offset:8192
  v_mfma_f32_16x16x32_bf16 v[56:59], v[148:151], v[120:123], v[56:59]
  ds_read_b64_tr_b16 v[222:223], v17 offset:9216
  v_mfma_f32_16x16x32_bf16 v[60:63], v[148:151], v[124:127], v[60:63]
  s_add_u32 s61, s61, 32768
  s_and_b32 s61, s61, 131071
  v_mfma_f32_16x16x32_bf16 v[64:67], v[152:155], v[112:115], v[64:67]
  v_add_u32 v10, s61, v2
  v_add_u32 v11, s61, v3
  v_mfma_f32_16x16x32_bf16 v[68:71], v[152:155], v[116:119], v[68:71]
  v_add_u32 v12, s61, v4
  v_add_u32 v13, s61, v5
  v_mfma_f32_16x16x32_bf16 v[72:75], v[152:155], v[120:123], v[72:75]
  v_add_u32 v14, s61, v6
  v_add_u32 v15, s61, v7
  v_mfma_f32_16x16x32_bf16 v[76:79], v[152:155], v[124:127], v[76:79]
  v_add_u32 v16, s61, v8
  v_add_u32 v17, s61, v9
  v_mfma_f32_16x16x32_bf16 v[80:83], v[156:159], v[112:115], v[80:83]
  v_mfma_f32_16x16x32_bf16 v[84:87], v[156:159], v[116:119], v[84:87]
  v_mfma_f32_16x16x32_bf16 v[88:91], v[156:159], v[120:123], v[88:91]
  v_mfma_f32_16x16x32_bf16 v[92:95], v[156:159], v[124:127], v[92:95]
  s_waitcnt lgkmcnt(0)
  s_barrier
  ds_read_b128 v[96:99], v10 offset:0
  v_mfma_f32_16x16x32_bf16 v[32:35], v[192:195], v[160:163], v[32:35]
  ds_read_b64_tr_b16 v[128:129], v14 offset:0
  v_mfma_f32_16x16x32_bf16 v[36:39], v[192:195], v[164:167], v[36:39]
  ds_read_b64_tr_b16 v[130:131], v14 offset:1024
  v_mfma_f32_16x16x32_bf16 v[40:43], v[192:195], v[168:171], v[40:43]
  ds_read_b128 v[100:103], v10 offset:2048
  v_mfma_f32_16x16x32_bf16 v[44:47], v[192:195], v[172:175], v[44:47]
  ds_read_b64_tr_b16 v[132:133], v15 offset:0
  v_mfma_f32_16x16x32_bf16 v[48:51], v[196:199], v[160:163], v[48:51]
  ds_read_b64_tr_b16 v[134:135], v15 offset:1024
  v_mfma_f32_16x16x32_bf16 v[52:55], v[196:199], v[164:167], v[52:55]
  ds_read_b128 v[104:107], v12 offset:0
  v_mfma_f32_16x16x32_bf16 v[56:59], v[196:199], v[168:171], v[56:59]
  ds_read_b64_tr_b16 v[136:137], v16 offset:0
  v_mfma_f32_16x16x32_bf16 v[60:63], v[196:199], v[172:175], v[60:63]
  ds_read_b64_tr_b16 v[138:139], v16 offset:1024
  v_mfma_f32_16x16x32_bf16 v[64:67], v[200:203], v[160:163], v[64:67]
  ds_read_b128 v[108:111], v12 offset:2048
  v_mfma_f32_16x16x32_bf16 v[68:71], v[200:203], v[164:167], v[68:71]
  ds_read_b64_tr_b16 v[140:141], v17 offset:0
  v_mfma_f32_16x16x32_bf16 v[72:75], v[200:203], v[168:171], v[72:75]
  ds_read_b64_tr_b16 v[142:143], v17 offset:1024
  v_mfma_f32_16x16x32_bf16 v[76:79], v[200:203], v[172:175], v[76:79]
  ds_read_b128 v[112:115], v11 offset:0
  v_mfma_f32_16x16x32_bf16 v[80:83], v[204:207], v[160:163], v[80:83]
  ds_read_b64_tr_b16 v[144:145], v14 offset:8192
  v_mfma_f32_16x16x32_bf16 v[84:87], v[204:207], v[164:167], v[84:87]
  ds_read_b64_tr_b16 v[146:147], v14 offset:9216
  v_mfma_f32_16x16x32_bf16 v[88:91], v[204:207], v[168:171], v[88:91]
  ds_read_b128 v[116:119], v11 offset:2048
  v_mfma_f32_16x16x32_bf16 v[92:95], v[204:207], v[172:175], v[92:95]
  ds_read_b64_tr_b16 v[148:149], v15 offset:8192
  v_mfma_f32_16x16x32_bf16 v[32:35], v[208:211], v[176:179], v[32:35]
  ds_read_b64_tr_b16 v[150:151], v15 offset:9216
  v_mfma_f32_16x16x32_bf16 v[36:39], v[208:211], v[180:183], v[36:39]
  ds_read_b128 v[120:123], v13 offset:0
  v_mfma_f32_16x16x32_bf16 v[40:43], v[208:211], v[184:187], v[40:43]
  ds_read_b64_tr_b16 v[152:153], v16 offset:8192
  v_mfma_f32_16x16x32_bf16 v[44:47], v[208:211], v[188:191], v[44:47]
  ds_read_b64_tr_b16 v[154:155], v16 offset:9216
  v_mfma_f32_16x16x32_bf16 v[48:51], v[212:215], v[176:179], v[48:51]
  ds_read_b128 v[124:127], v13 offset:2048
  v_mfma_f32_16x16x32_bf16 v[52:55], v[212:215], v[180:183], v[52:55]
  ds_read_b64_tr_b16 v[156:157], v17 offset:8192
  v_mfma_f32_16x16x32_bf16 v[56:59], v[212:215], v[184:187], v[56:59]
  ds_read_b64_tr_b16 v[158:159], v17 offset:9216
  v_mfma_f32_16x16x32_bf16 v[60:63], v[212:215], v[188:191], v[60:63]
  s_add_u32 s61, s61, 32768
  s_and_b32 s61, s61, 131071
  v_mfma_f32_16x16x32_bf16 v[64:67], v[216:219], v[176:179], v[64:67]
  v_add_u32 v10, s61, v2
  v_add_u32 v11, s61, v3
  v_mfma_f32_16x16x32_bf16 v[68:71], v[216:219], v[180:183], v[68:71]
  v_add_u32 v12, s61, v4
  v_add_u32 v13, s61, v5
  v_mfma_f32_16x16x32_bf16 v[72:75], v[216:219], v[184:187], v[72:75]
  v_add_u32 v14, s61, v6
  v_add_u32 v15, s61, v7
  v_mfma_f32_16x16x32_bf16 v[76:79], v[216:219], v[188:191], v[76:79]
  v_add_u32 v16, s61, v8
  v_add_u32 v17, s61, v9
  v_mfma_f32_16x16x32_bf16 v[80:83], v[220:223], v[176:179], v[80:83]
  s_add_u32 s62, s62, 1
  s_cmp_lt_u32 s62, 11
  v_mfma_f32_16x16x32_bf16 v[84:87], v[220:223], v[180:183], v[84:87]
  v_mfma_f32_16x16x32_bf16 v[88:91], v[220:223], v[184:187], v[88:91]
  v_mfma_f32_16x16x32_bf16 v[92:95], v[220:223], v[188:191], v[92:95]
  s_cbranch_scc1 L_c_loop
  buffer_load_dwordx2 v[26:27], v23, s[48:51], 0 offen sc0 sc1
  s_mov_b32 s64, 4096
  v_mov_b32 v20, 1
  s_waitcnt lgkmcnt(0)
  s_barrier
  ds_read_b128 v[168:171], v12 offset:0
  ds_read_b64_tr_b16 v[192:193], v14 offset:0
  v_mfma_f32_16x16x32_bf16 v[40:43], v[128:131], v[104:107], v[40:43]
  ds_read_b64_tr_b16 v[194:195], v14 offset:1024
  ds_read_b64_tr_b16 v[196:197], v15 offset:0
  v_mfma_f32_16x16x32_bf16 v[44:47], v[128:131], v[108:111], v[44:47]
  ds_read_b64_tr_b16 v[198:199], v15 offset:1024
  ds_read_b128 v[172:175], v12 offset:2048
  v_mfma_f32_16x16x32_bf16 v[56:59], v[132:135], v[104:107], v[56:59]
  ds_read_b64_tr_b16 v[200:201], v16 offset:0
  ds_read_b64_tr_b16 v[202:203], v16 offset:1024
  v_mfma_f32_16x16x32_bf16 v[60:63], v[132:135], v[108:111], v[60:63]
  ds_read_b64_tr_b16 v[204:205], v17 offset:0
  ds_read_b64_tr_b16 v[206:207], v17 offset:1024
  v_mfma_f32_16x16x32_bf16 v[72:75], v[136:139], v[104:107], v[72:75]
  ds_read_b128 v[184:187], v13 offset:0
  ds_read_b64_tr_b16 v[208:209], v14 offset:8192
  v_mfma_f32_16x16x32_bf16 v[76:79], v[136:139], v[108:111], v[76:79]
  ds_read_b64_tr_b16 v[210:211], v14 offset:9216
  ds_read_b64_tr_b16 v[212:213], v15 offset:8192
  v_mfma_f32_16x16x32_bf16 v[88:91], v[140:143], v[104:107], v[88:91]
  ds_read_b64_tr_b16 v[214:215], v15 offset:9216
  ds_read_b128 v[188:191], v13 offset:2048
  v_mfma_f32_16x16x32_bf16 v[92:95], v[140:143], v[108:111], v[92:95]
  ds_read_b64_tr_b16 v[216:217], v16 offset:8192
  ds_read_b64_tr_b16 v[218:219], v16 offset:9216
  v_mfma_f32_16x16x32_bf16 v[40:43], v[144:147], v[120:123], v[40:43]
  ds_read_b64_tr_b16 v[220:221], v17 offset:8192
  ds_read_b64_tr_b16 v[222:223], v17 offset:9216
  v_mfma_f32_16x16x32_bf16 v[44:47], v[144:147], v[124:127], v[44:47]
  v_mov_b32 v12, v4
  v_mov_b32 v13, v5
  v_mfma_f32_16x16x32_bf16 v[56:59], v[148:151], v[120:123], v[56:59]
  v_mov_b32 v14, v6
  v_mov_b32 v15, v7
  v_mfma_f32_16x16x32_bf16 v[60:63], v[148:151], v[124:127], v[60:63]
  v_mov_b32 v16, v8
  v_mov_b32 v17, v9
  v_mfma_f32_16x16x32_bf16 v[72:75], v[152:155], v[120:123], v[72:75]
  v_mfma_f32_16x16x32_bf16 v[76:79], v[152:155], v[124:127], v[76:79]
  v_mfma_f32_16x16x32_bf16 v[88:91], v[156:159], v[120:123], v[88:91]
  v_mfma_f32_16x16x32_bf16 v[92:95], v[156:159], v[124:127], v[92:95]
  s_waitcnt lgkmcnt(0)
  s_barrier
  ds_read_b128 v[104:107], v12 offset:0
  ds_read_b64_tr_b16 v[128:129], v14 offset:0
  v_mfma_f32_16x16x32_bf16 v[40:43], v[192:195], v[168:171], v[40:43]
  ds_read_b64_tr_b16 v[130:131], v14 offset:1024
  ds_read_b64_tr_b16 v[132:133], v15 offset:0
  v_mfma_f32_16x16x32_bf16 v[44:47], v[192:195], v[172:175], v[44:47]
  ds_read_b64_tr_b16 v[134:135], v15 offset:1024
  ds_read_b128 v[108:111], v12 offset:2048
  v_mfma_f32_16x16x32_bf16 v[56:59], v[196:199], v[168:171], v[56:59]
  ds_read_b64_tr_b16 v[136:137], v16 offset:0
  ds_read_b64_tr_b16 v[138:139], v16 offset:1024
  v_mfma_f32_16x16x32_bf16 v[60:63], v[196:199], v[172:175], v[60:63]
  ds_read_b64_tr_b16 v[140:141], v17 offset:0
  ds_read_b64_tr_b16 v[142:143], v17 offset:1024
  v_mfma_f32_16x16x32_bf16 v[72:75], v[200:203], v[168:171], v[72:75]
  ds_read_b128 v[120:123], v13 offset:0
  ds_read_b64_tr_b16 v[144:145], v14 offset:8192
  v_mfma_f32_16x16x32_bf16 v[76:79], v[200:203], v[172:175], v[76:79]
  ds_read_b64_tr_b16 v[146:147], v14 offset:9216
  ds_read_b64_tr_b16 v[148:149], v15 offset:8192
  v_mfma_f32_16x16x32_bf16 v[88:91], v[204:207], v[168:171], v[88:91]
  ds_read_b64_tr_b16 v[150:151], v15 offset:9216
  ds_read_b128 v[124:127], v13 offset:2048
  v_mfma_f32_16x16x32_bf16 v[92:95], v[204:207], v[172:175], v[92:95]
  ds_read_b64_tr_b16 v[152:153], v16 offset:8192
  ds_read_b64_tr_b16 v[154:155], v16 offset:9216
  v_mfma_f32_16x16x32_bf16 v[40:43], v[208:211], v[184:187], v[40:43]
  ds_read_b64_tr_b16 v[156:157], v17 offset:8192
  ds_read_b64_tr_b16 v[158:159], v17 offset:9216
  v_mfma_f32_16x16x32_bf16 v[44:47], v[208:211], v[188:191], v[44:47]
  v_add_u32 v12, 32768, v4
  v_add_u32 v13, 32768, v5
  v_mfma_f32_16x16x32_bf16 v[56:59], v[212:215], v[184:187], v[56:59]
  v_add_u32 v14, 32768, v6
  v_add_u32 v15, 32768, v7
  v_mfma_f32_16x16x32_bf16 v[60:63], v[212:215], v[188:191], v[60:63]
  v_add_u32 v16, 32768, v8
  v_add_u32 v17, 32768, v9
  v_mfma_f32_16x16x32_bf16 v[72:75], v[216:219], v[184:187], v[72:75]
  v_mfma_f32_16x16x32_bf16 v[76:79], v[216:219], v[188:191], v[76:79]
  v_mfma_f32_16x16x32_bf16 v[88:91], v[220:223], v[184:187], v[88:91]
  v_mfma_f32_16x16x32_bf16 v[92:95], v[220:223], v[188:191], v[92:95]
  s_waitcnt lgkmcnt(0)
  s_barrier
  ds_read_b128 v[168:171], v12 offset:0
  ds_read_b64_tr_b16 v[192:193], v14 offset:0
  v_mfma_f32_16x16x32_bf16 v[40:43], v[128:131], v[104:107], v[40:43]
  ds_read_b64_tr_b16 v[194:195], v14 offset:1024
  ds_read_b64_tr_b16 v[196:197], v15 offset:0
  v_mfma_f32_16x16x32_bf16 v[44:47], v[128:131], v[108:111], v[44:47]
  ds_read_b64_tr_b16 v[198:199], v15 offset:1024
  ds_read_b128 v[172:175], v12 offset:2048
  v_mfma_f32_16x16x32_bf16 v[56:59], v[132:135], v[104:107], v[56:59]
  ds_read_b64_tr_b16 v[200:201], v16 offset:0
  ds_read_b64_tr_b16 v[202:203], v16 offset:1024
  v_mfma_f32_16x16x32_bf16 v[60:63], v[132:135], v[108:111], v[60:63]
  ds_read_b64_tr_b16 v[204:205], v17 offset:0
  ds_read_b64_tr_b16 v[206:207], v17 offset:1024
  v_mfma_f32_16x16x32_bf16 v[72:75], v[136:139], v[104:107], v[72:75]
  ds_read_b128 v[184:187], v13 offset:0
  ds_read_b64_tr_b16 v[208:209], v14 offset:8192
  v_mfma_f32_16x16x32_bf16 v[76:79], v[136:139], v[108:111], v[76:79]
  ds_read_b64_tr_b16 v[210:211], v14 offset:9216
  ds_read_b64_tr_b16 v[212:213], v15 offset:8192
  v_mfma_f32_16x16x32_bf16 v[88:91], v[140:143], v[104:107], v[88:91]
  ds_read_b64_tr_b16 v[214:215], v15 offset:9216
  ds_read_b128 v[188:191], v13 offset:2048
  v_mfma_f32_16x16x32_bf16 v[92:95], v[140:143], v[108:111], v[92:95]
  ds_read_b64_tr_b16 v[216:217], v16 offset:8192
  ds_read_b64_tr_b16 v[218:219], v16 offset:9216
  v_mfma_f32_16x16x32_bf16 v[40:43], v[144:147], v[120:123], v[40:43]
  ds_read_b64_tr_b16 v[220:221], v17 offset:8192
  ds_read_b64_tr_b16 v[222:223], v17 offset:9216
  v_mfma_f32_16x16x32_bf16 v[44:47], v[144:147], v[124:127], v[44:47]
  v_add_u32 v14, 65536, v6
  v_add_u32 v15, 65536, v7
  v_mfma_f32_16x16x32_bf16 v[56:59], v[148:151], v[120:123], v[56:59]
  v_add_u32 v16, 65536, v8
  v_add_u32 v17, 65536, v9
  v_mfma_f32_16x16x32_bf16 v[60:63], v[148:151], v[124:127], v[60:63]
  v_mfma_f32_16x16x32_bf16 v[72:75], v[152:155], v[120:123], v[72:75]
  v_mfma_f32_16x16x32_bf16 v[76:79], v[152:155], v[124:127], v[76:79]
  v_mfma_f32_16x16x32_bf16 v[88:91], v[156:159], v[120:123], v[88:91]
  v_mfma_f32_16x16x32_bf16 v[92:95], v[156:159], v[124:127], v[92:95]
  s_waitcnt lgkmcnt(0)
  ds_read_b64_tr_b16 v[128:129], v14 offset:0
  ds_read_b64_tr_b16 v[130:131], v14 offset:1024
  v_mfma_f32_16x16x32_bf16 v[40:43], v[192:195], v[168:171], v[40:43]
  ds_read_b64_tr_b16 v[132:133], v15 offset:0
  ds_read_b64_tr_b16 v[134:135], v15 offset:1024
  v_mfma_f32_16x16x32_bf16 v[44:47], v[192:195], v[172:175], v[44:47]
  ds_read_b64_tr_b16 v[136:137], v16 offset:0
  ds_read_b64_tr_b16 v[138:139], v16 offset:1024
  v_mfma_f32_16x16x32_bf16 v[56:59], v[196:199], v[168:171], v[56:59]
  ds_read_b64_tr_b16 v[140:141], v17 offset:0
  ds_read_b64_tr_b16 v[142:143], v17 offset:1024
  v_mfma_f32_16x16x32_bf16 v[60:63], v[196:199], v[172:175], v[60:63]
  ds_read_b64_tr_b16 v[144:145], v14 offset:8192
  ds_read_b64_tr_b16 v[146:147], v14 offset:9216
  v_mfma_f32_16x16x32_bf16 v[72:75], v[200:203], v[168:171], v[72:75]
  ds_read_b64_tr_b16 v[148:149], v15 offset:8192
  ds_read_b64_tr_b16 v[150:151], v15 offset:9216
  v_mfma_f32_16x16x32_bf16 v[76:79], v[200:203], v[172:175], v[76:79]
  ds_read_b64_tr_b16 v[152:153], v16 offset:8192
  ds_read_b64_tr_b16 v[154:155], v16 offset:9216
  v_mfma_f32_16x16x32_bf16 v[88:91], v[204:207], v[168:171], v[88:91]
  ds_read_b64_tr_b16 v[156:157], v17 offset:8192
  ds_read_b64_tr_b16 v[158:159], v17 offset:9216
  v_mfma_f32_16x16x32_bf16 v[92:95], v[204:207], v[172:175], v[92:95]
  v_add_u32 v10, 98304, v2
  v_add_u32 v11, 98304, v3
  v_mfma_f32_16x16x32_bf16 v[40:43], v[208:211], v[184:187], v[40:43]
  v_add_u32 v14, 98304, v6
  v_add_u32 v15, 98304, v7
  v_mfma_f32_16x16x32_bf16 v[44:47], v[208:211], v[188:191], v[44:47]
  v_add_u32 v16, 98304, v8
  v_add_u32 v17, 98304, v9
  v_mfma_f32_16x16x32_bf16 v[56:59], v[212:215], v[184:187], v[56:59]
  v_mfma_f32_16x16x32_bf16 v[60:63], v[212:215], v[188:191], v[60:63]
  v_mfma_f32_16x16x32_bf16 v[72:75], v[216:219], v[184:187], v[72:75]
  v_mfma_f32_16x16x32_bf16 v[76:79], v[216:219], v[188:191], v[76:79]
  v_mfma_f32_16x16x32_bf16 v[88:91], v[220:223], v[184:187], v[88:91]
  v_mfma_f32_16x16x32_bf16 v[92:95], v[220:223], v[188:191], v[92:95]
  s_waitcnt lgkmcnt(0)
  ds_read_b128 v[160:163], v10 offset:0
  ds_read_b64_tr_b16 v[192:193], v14 offset:0
  v_mfma_f32_16x16x32_bf16 v[32:35], v[128:131], v[96:99], v[32:35]
  ds_read_b64_tr_b16 v[194:195], v14 offset:1024
  ds_read_b64_tr_b16 v[196:197], v15 offset:0
  v_mfma_f32_16x16x32_bf16 v[36:39], v[128:131], v[100:103], v[36:39]
  ds_read_b64_tr_b16 v[198:199], v15 offset:1024
  ds_read_b128 v[164:167], v10 offset:2048
  v_mfma_f32_16x16x32_bf16 v[48:51], v[132:135], v[96:99], v[48:51]
  ds_read_b64_tr_b16 v[200:201], v16 offset:0
  ds_read_b64_tr_b16 v[202:203], v16 offset:1024
  v_mfma_f32_16x16x32_bf16 v[52:55], v[132:135], v[100:103], v[52:55]
  buffer_store_dwordx4 v[40:43], v22, s[44:47], 0 offen offset:0 sc0 sc1
  buffer_store_dwordx4 v[44:47], v22, s[44:47], 0 offen offset:1024 sc0 sc1
  v_mfma_f32_16x16x32_bf16 v[64:67], v[136:139], v[96:99], v[64:67]
  buffer_store_dwordx4 v[56:59], v22, s[44:47], 0 offen offset:2048 sc0 sc1
  buffer_store_dwordx4 v[60:63], v22, s[44:47], 0 offen offset:3072 sc0 sc1
  v_mfma_f32_16x16x32_bf16 v[68:71], v[136:139], v[100:103], v[68:71]
  buffer_store_dwordx4 v[72:75], v22, s[44:47], s64 offen offset:0 sc0 sc1
  buffer_store_dwordx4 v[76:79], v22, s[44:47], s64 offen offset:1024 sc0 sc1
  v_mfma_f32_16x16x32_bf16 v[80:83], v[140:143], v[96:99], v[80:83]
  buffer_store_dwordx4 v[88:91], v22, s[44:47], s64 offen offset:2048 sc0 sc1
  buffer_store_dwordx4 v[92:95], v22, s[44:47], s64 offen offset:3072 sc0 sc1
  v_mfma_f32_16x16x32_bf16 v[84:87], v[140:143], v[100:103], v[84:87]
  ds_read_b64_tr_b16 v[204:205], v17 offset:0
  ds_read_b64_tr_b16 v[206:207], v17 offset:1024
  v_mfma_f32_16x16x32_bf16 v[32:35], v[144:147], v[112:115], v[32:35]
  ds_read_b128 v[176:179], v11 offset:0
  ds_read_b64_tr_b16 v[208:209], v14 offset:8192
  v_mfma_f32_16x16x32_bf16 v[36:39], v[144:147], v[116:119], v[36:39]
  ds_read_b64_tr_b16 v[210:211], v14 offset:9216
  ds_read_b64_tr_b16 v[212:213], v15 offset:8192
  v_mfma_f32_16x16x32_bf16 v[48:51], v[148:151], v[112:115], v[48:51]
  ds_read_b64_tr_b16 v[214:215], v15 offset:9216
  ds_read_b128 v[180:183], v11 offset:2048
  v_mfma_f32_16x16x32_bf16 v[52:55], v[148:151], v[116:119], v[52:55]
  ds_read_b64_tr_b16 v[216:217], v16 offset:8192
  ds_read_b64_tr_b16 v[218:219], v16 offset:9216
  v_mfma_f32_16x16x32_bf16 v[64:67], v[152:155], v[112:115], v[64:67]
  ds_read_b64_tr_b16 v[220:221], v17 offset:8192
  ds_read_b64_tr_b16 v[222:223], v17 offset:9216
  v_mfma_f32_16x16x32_bf16 v[68:71], v[152:155], v[116:119], v[68:71]
  v_mov_b32 v10, v2
  v_mov_b32 v11, v3
  v_mfma_f32_16x16x32_bf16 v[80:83], v[156:159], v[112:115], v[80:83]
  v_mov_b32 v14, v6
  v_mov_b32 v15, v7
  v_mfma_f32_16x16x32_bf16 v[84:87], v[156:159], v[116:119], v[84:87]
  v_mov_b32 v16, v8
  v_mov_b32 v17, v9
  s_waitcnt lgkmcnt(0)
  ds_read_b128 v[96:99], v10 offset:0
  ds_read_b64_tr_b16 v[128:129], v14 offset:0
  v_mfma_f32_16x16x32_bf16 v[32:35], v[192:195], v[160:163], v[32:35]
  ds_read_b64_tr_b16 v[130:131], v14 offset:1024
  ds_read_b64_tr_b16 v[132:133], v15 offset:0
  v_mfma_f32_16x16x32_bf16 v[36:39], v[192:195], v[164:167], v[36:39]
  ds_read_b64_tr_b16 v[134:135], v15 offset:1024
  ds_read_b128 v[100:103], v10 offset:2048
  v_mfma_f32_16x16x32_bf16 v[48:51], v[196:199], v[160:163], v[48:51]
  ds_read_b64_tr_b16 v[136:137], v16 offset:0
  ds_read_b64_tr_b16 v[138:139], v16 offset:1024
  v_mfma_f32_16x16x32_bf16 v[52:55], v[196:199], v[164:167], v[52:55]
  ds_read_b64_tr_b16 v[140:141], v17 offset:0
  ds_read_b64_tr_b16 v[142:143], v17 offset:1024
  v_mfma_f32_16x16x32_bf16 v[64:67], v[200:203], v[160:163], v[64:67]
  ds_read_b128 v[112:115], v11 offset:0
  ds_read_b64_tr_b16 v[144:145], v14 offset:8192
  v_mfma_f32_16x16x32_bf16 v[68:71], v[200:203], v[164:167], v[68:71]
  ds_read_b64_tr_b16 v[146:147], v14 offset:9216
  ds_read_b64_tr_b16 v[148:149], v15 offset:8192
  v_mfma_f32_16x16x32_bf16 v[80:83], v[204:207], v[160:163], v[80:83]
  ds_read_b64_tr_b16 v[150:151], v15 offset:9216
  ds_read_b128 v[116:119], v11 offset:2048
  v_mfma_f32_16x16x32_bf16 v[84:87], v[204:207], v[164:167], v[84:87]
  ds_read_b64_tr_b16 v[152:153], v16 offset:8192
  ds_read_b64_tr_b16 v[154:155], v16 offset:9216
  v_mfma_f32_16x16x32_bf16 v[32:35], v[208:211], v[176:179], v[32:35]
  ds_read_b64_tr_b16 v[156:157], v17 offset:8192
  ds_read_b64_tr_b16 v[158:159], v17 offset:9216
  v_mfma_f32_16x16x32_bf16 v[36:39], v[208:211], v[180:183], v[36:39]
  v_add_u32 v10, 32768, v2
  v_add_u32 v11, 32768, v3
  v_mfma_f32_16x16x32_bf16 v[48:51], v[212:215], v[176:179], v[48:51]
  v_add_u32 v14, 32768, v6
  v_add_u32 v15, 32768, v7
  v_mfma_f32_16x16x32_bf16 v[52:55], v[212:215], v[180:183], v[52:55]
  v_add_u32 v16, 32768, v8
  v_add_u32 v17, 32768, v9
  v_mfma_f32_16x16x32_bf16 v[64:67], v[216:219], v[176:179], v[64:67]
  v_mfma_f32_16x16x32_bf16 v[68:71], v[216:219], v[180:183], v[68:71]
  v_mfma_f32_16x16x32_bf16 v[80:83], v[220:223], v[176:179], v[80:83]
  v_mfma_f32_16x16x32_bf16 v[84:87], v[220:223], v[180:183], v[84:87]
  s_waitcnt lgkmcnt(0)
  ds_read_b128 v[160:163], v10 offset:0
  ds_read_b64_tr_b16 v[192:193], v14 offset:0
  v_mfma_f32_16x16x32_bf16 v[32:35], v[128:131], v[96:99], v[32:35]
  ds_read_b64_tr_b16 v[194:195], v14 offset:1024
  ds_read_b64_tr_b16 v[196:197], v15 offset:0
  v_mfma_f32_16x16x32_bf16 v[36:39], v[128:131], v[100:103], v[36:39]
  ds_read_b64_tr_b16 v[198:199], v15 offset:1024
  ds_read_b128 v[164:167], v10 offset:2048
  v_mfma_f32_16x16x32_bf16 v[48:51], v[132:135], v[96:99], v[48:51]
  ds_read_b64_tr_b16 v[200:201], v16 offset:0
  ds_read_b64_tr_b16 v[202:203], v16 offset:1024
  v_mfma_f32_16x16x32_bf16 v[52:55], v[132:135], v[100:103], v[52:55]
  ds_read_b64_tr_b16 v[204:205], v17 offset:0
  ds_read_b64_tr_b16 v[206:207], v17 offset:1024
  v_mfma_f32_16x16x32_bf16 v[64:67], v[136:139], v[96:99], v[64:67]
  ds_read_b128 v[176:179], v11 offset:0
  ds_read_b64_tr_b16 v[208:209], v14 offset:8192
  v_mfma_f32_16x16x32_bf16 v[68:71], v[136:139], v[100:103], v[68:71]
  ds_read_b64_tr_b16 v[210:211], v14 offset:9216
  ds_read_b64_tr_b16 v[212:213], v15 offset:8192
  v_mfma_f32_16x16x32_bf16 v[80:83], v[140:143], v[96:99], v[80:83]
  ds_read_b64_tr_b16 v[214:215], v15 offset:9216
  ds_read_b128 v[180:183], v11 offset:2048
  v_mfma_f32_16x16x32_bf16 v[84:87], v[140:143], v[100:103], v[84:87]
  ds_read_b64_tr_b16 v[216:217], v16 offset:8192
  ds_read_b64_tr_b16 v[218:219], v16 offset:9216
  v_mfma_f32_16x16x32_bf16 v[32:35], v[144:147], v[112:115], v[32:35]
  ds_read_b64_tr_b16 v[220:221], v17 offset:8192
  ds_read_b64_tr_b16 v[222:223], v17 offset:9216
  v_mfma_f32_16x16x32_bf16 v[36:39], v[144:147], v[116:119], v[36:39]
  v_mfma_f32_16x16x32_bf16 v[48:51], v[148:151], v[112:115], v[48:51]
  v_mfma_f32_16x16x32_bf16 v[52:55], v[148:151], v[116:119], v[52:55]
  v_mfma_f32_16x16x32_bf16 v[64:67], v[152:155], v[112:115], v[64:67]
  v_mfma_f32_16x16x32_bf16 v[68:71], v[152:155], v[116:119], v[68:71]
  v_mfma_f32_16x16x32_bf16 v[80:83], v[156:159], v[112:115], v[80:83]
  v_mfma_f32_16x16x32_bf16 v[84:87], v[156:159], v[116:119], v[84:87]
  s_waitcnt vmcnt(0)
  s_mov_b64 exec, 1
  buffer_store_dword v20, v24, s[44:47], 0 offen sc0 sc1
  s_mov_b64 exec, -1
  s_waitcnt lgkmcnt(0)
  v_lshlrev_b32 v128, 16, v226
  v_and_b32 v129, 0xffff0000, v226
  v_mfma_f32_16x16x32_bf16 v[32:35], v[192:195], v[160:163], v[32:35]
  v_lshlrev_b32 v130, 16, v227
  v_and_b32 v131, 0xffff0000, v227
  v_mfma_f32_16x16x32_bf16 v[36:39], v[192:195], v[164:167], v[36:39]
  v_lshlrev_b32 v132, 16, v228
  v_and_b32 v133, 0xffff0000, v228
  v_mfma_f32_16x16x32_bf16 v[48:51], v[196:199], v[160:163], v[48:51]
  v_lshlrev_b32 v134, 16, v229
  v_and_b32 v135, 0xffff0000, v229
  v_mfma_f32_16x16x32_bf16 v[52:55], v[196:199], v[164:167], v[52:55]
  v_lshlrev_b32 v136, 16, v230
  v_and_b32 v137, 0xffff0000, v230
  v_mfma_f32_16x16x32_bf16 v[64:67], v[200:203], v[160:163], v[64:67]
  v_lshlrev_b32 v138, 16, v231
  v_and_b32 v139, 0xffff0000, v231
  v_mfma_f32_16x16x32_bf16 v[68:71], v[200:203], v[164:167], v[68:71]
  v_lshlrev_b32 v140, 16, v232
  v_and_b32 v141, 0xffff0000, v232
  v_mfma_f32_16x16x32_bf16 v[80:83], v[204:207], v[160:163], v[80:83]
  v_lshlrev_b32 v142, 16, v233
  v_and_b32 v143, 0xffff0000, v233
  v_mfma_f32_16x16x32_bf16 v[84:87], v[204:207], v[164:167], v[84:87]
  v_xor_b32 v19, 32768, v22
  v_xor_b32 v18, 512, v24
  v_mfma_f32_16x16x32_bf16 v[32:35], v[208:211], v[176:179], v[32:35]
  v_mov_b32 v28, 0
  v_mov_b32 v29, 0
  v_mfma_f32_16x16x32_bf16 v[36:39], v[208:211], v[180:183], v[36:39]
  v_mfma_f32_16x16x32_bf16 v[48:51], v[212:215], v[176:179], v[48:51]
  v_mfma_f32_16x16x32_bf16 v[52:55], v[212:215], v[180:183], v[52:55]
  v_mfma_f32_16x16x32_bf16 v[64:67], v[216:219], v[176:179], v[64:67]
  v_mfma_f32_16x16x32_bf16 v[68:71], v[216:219], v[180:183], v[68:71]
  v_mfma_f32_16x16x32_bf16 v[80:83], v[220:223], v[176:179], v[80:83]
  v_mfma_f32_16x16x32_bf16 v[84:87], v[220:223], v[180:183], v[84:87]
  s_mov_b32 s62, 0
L_c_flchk:
  v_readfirstlane_b32 s63, v26
  v_readfirstlane_b32 s65, v27
  s_nop 2
  s_cmp_eq_u32 s58, 0
  s_cselect_b32 s63, s65, s63
  s_lshl_b32 s65, s57, 3
  s_bitcmp1_b32 s63, s65
  s_cbranch_scc1 L_c_poll
  s_add_u32 s62, s62, 1
  s_cmp_gt_u32 s62, 1048576
  s_cbranch_scc1 L_c_poll
  buffer_load_dwordx2 v[26:27], v23, s[48:51], 0 offen sc0 sc1
  s_waitcnt vmcnt(0)
  s_branch L_c_flchk
L_c_poll:
  buffer_load_dword v21, v18, s[44:47], 0 offen sc0 sc1
  s_waitcnt vmcnt(0)
  v_readfirstlane_b32 s63, v21
  s_nop 3
  s_cmp_eq_u32 s63, 1
  s_cbranch_scc1 L_c_got
  s_add_u32 s62, s62, 1
  s_cmp_lt_u32 s62, 1048576
  s_cbranch_scc1 L_c_poll
L_c_got:
  buffer_load_dwordx4 v[96:99], v19, s[44:47], 0 offen offset:0 sc0 sc1
  buffer_load_dwordx4 v[100:103], v19, s[44:47], 0 offen offset:1024 sc0 sc1
  buffer_load_dwordx4 v[104:107], v19, s[44:47], 0 offen offset:2048 sc0 sc1
  buffer_load_dwordx4 v[108:111], v19, s[44:47], 0 offen offset:3072 sc0 sc1
  buffer_load_dwordx4 v[112:115], v19, s[44:47], s64 offen offset:0 sc0 sc1
  buffer_load_dwordx4 v[116:119], v19, s[44:47], s64 offen offset:1024 sc0 sc1
  buffer_load_dwordx4 v[120:123], v19, s[44:47], s64 offen offset:2048 sc0 sc1
  buffer_load_dwordx4 v[124:127], v19, s[44:47], s64 offen offset:3072 sc0 sc1
  v_lshrrev_b32 v18, 4, v0
  v_lshlrev_b32 v18, 8, v18
  v_and_b32 v19, 15, v0
  v_lshl_add_u32 v18, v19, 2, v18
  s_lshl_b32 s63, s60, 10
  s_lshl_b32 s64, s59, 7
  s_add_u32 s63, s63, s64
  s_add_u32 s63, s63, 144384
  v_add_u32 v18, s63, v18
  s_waitcnt vmcnt(6)
  v_pk_add_f32 v[96:97], v[96:97], v[32:33]
  v_pk_add_f32 v[98:99], v[98:99], v[34:35]
  v_pk_add_f32 v[100:101], v[100:101], v[36:37]
  v_pk_add_f32 v[102:103], v[102:103], v[38:39]
  v_cvt_pk_bf16_f32 v20, v96, v97
  v_lshlrev_b32 v30, 16, v20
  v_and_b32 v31, 0xffff0000, v20
  v_pk_add_f32 v[30:31], v[30:31], v[128:129]
  v_cvt_pk_bf16_f32 v20, v30, v31
  v_pk_min_i16 v30, v20, 0
  v_pk_max_i16 v20, v20, 0
  v_dot2_f32_bf16 v28, v30, 0, v28
  v_dot2_f32_bf16 v28, v20, v234, v28
  v_cvt_pk_bf16_f32 v21, v100, v101
  v_lshlrev_b32 v224, 16, v21
  v_and_b32 v225, 0xffff0000, v21
  v_pk_add_f32 v[224:225], v[224:225], v[128:129]
  v_cvt_pk_bf16_f32 v21, v224, v225
  v_pk_min_i16 v224, v21, 0
  v_pk_max_i16 v21, v21, 0
  v_dot2_f32_bf16 v29, v224, 0, v29
  v_dot2_f32_bf16 v29, v21, v234, v29
  v_cvt_pk_bf16_f32 v20, v98, v99
  v_lshlrev_b32 v30, 16, v20
  v_and_b32 v31, 0xffff0000, v20
  v_pk_add_f32 v[30:31], v[30:31], v[130:131]
  v_cvt_pk_bf16_f32 v20, v30, v31
  v_pk_min_i16 v30, v20, 0
  v_pk_max_i16 v20, v20, 0
  v_dot2_f32_bf16 v28, v30, 0, v28
  v_dot2_f32_bf16 v28, v20, v235, v28
  v_cvt_pk_bf16_f32 v21, v102, v103
  v_lshlrev_b32 v224, 16, v21
  v_and_b32 v225, 0xffff0000, v21
  v_pk_add_f32 v[224:225], v[224:225], v[130:131]
  v_cvt_pk_bf16_f32 v21, v224, v225
  v_pk_min_i16 v224, v21, 0
  v_pk_max_i16 v21, v21, 0
  v_dot2_f32_bf16 v29, v224, 0, v29
  v_dot2_f32_bf16 v29, v21, v235, v29
  s_waitcnt vmcnt(4)
  v_pk_add_f32 v[104:105], v[104:105], v[48:49]
  v_pk_add_f32 v[106:107], v[106:107], v[50:51]
  v_pk_add_f32 v[108:109], v[108:109], v[52:53]
  v_pk_add_f32 v[110:111], v[110:111], v[54:55]
  v_cvt_pk_bf16_f32 v20, v104, v105
  v_lshlrev_b32 v30, 16, v20
  v_and_b32 v31, 0xffff0000, v20
  v_pk_add_f32 v[30:31], v[30:31], v[132:133]
  v_cvt_pk_bf16_f32 v20, v30, v31
  v_pk_min_i16 v30, v20, 0
  v_pk_max_i16 v20, v20, 0
  v_dot2_f32_bf16 v28, v30, 0, v28
  v_dot2_f32_bf16 v28, v20, v236, v28
  v_cvt_pk_bf16_f32 v21, v108, v109
  v_lshlrev_b32 v224, 16, v21
  v_and_b32 v225, 0xffff0000, v21
  v_pk_add_f32 v[224:225], v[224:225], v[132:133]
  v_cvt_pk_bf16_f32 v21, v224, v225
  v_pk_min_i16 v224, v21, 0
  v_pk_max_i16 v21, v21, 0
  v_dot2_f32_bf16 v29, v224, 0, v29
  v_dot2_f32_bf16 v29, v21, v236, v29
  v_cvt_pk_bf16_f32 v20, v106, v107
  v_lshlrev_b32 v30, 16, v20
  v_and_b32 v31, 0xffff0000, v20
  v_pk_add_f32 v[30:31], v[30:31], v[134:135]
  v_cvt_pk_bf16_f32 v20, v30, v31
  v_pk_min_i16 v30, v20, 0
  v_pk_max_i16 v20, v20, 0
  v_dot2_f32_bf16 v28, v30, 0, v28
  v_dot2_f32_bf16 v28, v20, v237, v28
  v_cvt_pk_bf16_f32 v21, v110, v111
  v_lshlrev_b32 v224, 16, v21
  v_and_b32 v225, 0xffff0000, v21
  v_pk_add_f32 v[224:225], v[224:225], v[134:135]
  v_cvt_pk_bf16_f32 v21, v224, v225
  v_pk_min_i16 v224, v21, 0
  v_pk_max_i16 v21, v21, 0
  v_dot2_f32_bf16 v29, v224, 0, v29
  v_dot2_f32_bf16 v29, v21, v237, v29
  s_waitcnt vmcnt(2)
  v_pk_add_f32 v[112:113], v[112:113], v[64:65]
  v_pk_add_f32 v[114:115], v[114:115], v[66:67]
  v_pk_add_f32 v[116:117], v[116:117], v[68:69]
  v_pk_add_f32 v[118:119], v[118:119], v[70:71]
  v_cvt_pk_bf16_f32 v20, v112, v113
  v_lshlrev_b32 v30, 16, v20
  v_and_b32 v31, 0xffff0000, v20
  v_pk_add_f32 v[30:31], v[30:31], v[136:137]
  v_cvt_pk_bf16_f32 v20, v30, v31
  v_pk_min_i16 v30, v20, 0
  v_pk_max_i16 v20, v20, 0
  v_dot2_f32_bf16 v28, v30, 0, v28
  v_dot2_f32_bf16 v28, v20, v238, v28
  v_cvt_pk_bf16_f32 v21, v116, v117
  v_lshlrev_b32 v224, 16, v21
  v_and_b32 v225, 0xffff0000, v21
  v_pk_add_f32 v[224:225], v[224:225], v[136:137]
  v_cvt_pk_bf16_f32 v21, v224, v225
  v_pk_min_i16 v224, v21, 0
  v_pk_max_i16 v21, v21, 0
  v_dot2_f32_bf16 v29, v224, 0, v29
  v_dot2_f32_bf16 v29, v21, v238, v29
  v_cvt_pk_bf16_f32 v20, v114, v115
  v_lshlrev_b32 v30, 16, v20
  v_and_b32 v31, 0xffff0000, v20
  v_pk_add_f32 v[30:31], v[30:31], v[138:139]
  v_cvt_pk_bf16_f32 v20, v30, v31
  v_pk_min_i16 v30, v20, 0
  v_pk_max_i16 v20, v20, 0
  v_dot2_f32_bf16 v28, v30, 0, v28
  v_dot2_f32_bf16 v28, v20, v239, v28
  v_cvt_pk_bf16_f32 v21, v118, v119
  v_lshlrev_b32 v224, 16, v21
  v_and_b32 v225, 0xffff0000, v21
  v_pk_add_f32 v[224:225], v[224:225], v[138:139]
  v_cvt_pk_bf16_f32 v21, v224, v225
  v_pk_min_i16 v224, v21, 0
  v_pk_max_i16 v21, v21, 0
  v_dot2_f32_bf16 v29, v224, 0, v29
  v_dot2_f32_bf16 v29, v21, v239, v29
  s_waitcnt vmcnt(0)
  v_pk_add_f32 v[120:121], v[120:121], v[80:81]
  v_pk_add_f32 v[122:123], v[122:123], v[82:83]
  v_pk_add_f32 v[124:125], v[124:125], v[84:85]
  v_pk_add_f32 v[126:127], v[126:127], v[86:87]
  v_cvt_pk_bf16_f32 v20, v120, v121
  v_lshlrev_b32 v30, 16, v20
  v_and_b32 v31, 0xffff0000, v20
  v_pk_add_f32 v[30:31], v[30:31], v[140:141]
  v_cvt_pk_bf16_f32 v20, v30, v31
  v_pk_min_i16 v30, v20, 0
  v_pk_max_i16 v20, v20, 0
  v_dot2_f32_bf16 v28, v30, 0, v28
  v_dot2_f32_bf16 v28, v20, v240, v28
  v_cvt_pk_bf16_f32 v21, v124, v125
  v_lshlrev_b32 v224, 16, v21
  v_and_b32 v225, 0xffff0000, v21
  v_pk_add_f32 v[224:225], v[224:225], v[140:141]
  v_cvt_pk_bf16_f32 v21, v224, v225
  v_pk_min_i16 v224, v21, 0
  v_pk_max_i16 v21, v21, 0
  v_dot2_f32_bf16 v29, v224, 0, v29
  v_dot2_f32_bf16 v29, v21, v240, v29
  v_cvt_pk_bf16_f32 v20, v122, v123
  v_lshlrev_b32 v30, 16, v20
  v_and_b32 v31, 0xffff0000, v20
  v_pk_add_f32 v[30:31], v[30:31], v[142:143]
  v_cvt_pk_bf16_f32 v20, v30, v31
  v_pk_min_i16 v30, v20, 0
  v_pk_max_i16 v20, v20, 0
  v_dot2_f32_bf16 v28, v30, 0, v28
  v_dot2_f32_bf16 v28, v20, v241, v28
  v_cvt_pk_bf16_f32 v21, v126, v127
  v_lshlrev_b32 v224, 16, v21
  v_and_b32 v225, 0xffff0000, v21
  v_pk_add_f32 v[224:225], v[224:225], v[142:143]
  v_cvt_pk_bf16_f32 v21, v224, v225
  v_pk_min_i16 v224, v21, 0
  v_pk_max_i16 v21, v21, 0
  v_dot2_f32_bf16 v29, v224, 0, v29
  v_dot2_f32_bf16 v29, v21, v241, v29
  s_nop 2
  ds_write_b32 v18, v28
  ds_write_b32 v18, v29 offset:64
  s_waitcnt lgkmcnt(0)
  s_barrier
L_end2:
  s_endpgm
.section .rodata,"a"
.p2align 6
.amdhsa_kernel standalone__deep_cross_wide_deep__recsys_kernel
  .amdhsa_next_free_vgpr 256
  .amdhsa_next_free_sgpr 96
  .amdhsa_accum_offset 256
  .amdhsa_group_segment_fixed_size 0
  .amdhsa_kernarg_size 96
  .amdhsa_user_sgpr_count 2
  .amdhsa_user_sgpr_kernarg_segment_ptr 1
  .amdhsa_system_sgpr_workgroup_id_x 1
.end_amdhsa_kernel
```
